```python
import torch

def _softmax(x, axis=-1):
    return torch.softmax(x, dim=axis)
def _gelu(x):
    return torch.nn.functional.gelu(x, approximate="tanh")
def _silu(x):
    return torch.nn.functional.silu(x)
def _sigmoid(x):
    return torch.sigmoid(x)
def _layernorm(x, axis=-1, eps=1e-5):
    m = x.mean(dim=axis, keepdim=True)
    v = x.var(dim=axis, keepdim=True, unbiased=False)
    return (x - m) / torch.sqrt(v + eps)
def _scatter_add(tgt, idx, src, axis=0):
    return tgt.clone().index_add_(axis, idx, src)
def _segment_sum(src, seg, n):
    out = torch.zeros((n,) + src.shape[1:], dtype=src.dtype)
    return out.index_add_(0, seg, src)
def _pad(x, pw):
    flat = tuple(v for pair in reversed(pw) for v in pair)
    return torch.nn.functional.pad(x, flat)

kernel_name = 'gated_mix__sliding_block_cached__dense_activation_relu__decode'

def setup_inputs():

    _w = (lambda a: (lambda t: t.to(torch.bfloat16) if t.is_floating_point() else t)(torch.as_tensor(a)))
    def _A_setup():
        B, Sq, D = 4, 1, 448
        Hq, Hkv, Sk, Dh = 16, 8, 8192, 256
        assert Hq % Hkv == 0, (Hq, Hkv)
        return {
            "x": _w((lambda *s: torch.randn(*s, dtype=torch.bfloat16) * 0.05)(B, Sq, D)),
            "k_cache": _w((lambda *s: torch.randn(*s, dtype=torch.bfloat16) * 6.4)(B, Hkv, Sk, Dh)),
            "v_cache": _w((lambda *s: torch.randn(*s, dtype=torch.bfloat16) * 0.4)(B, Hkv, Sk, Dh)),
            "wq": _w((lambda *s: torch.randn(*s, dtype=torch.bfloat16) * 6.4)(D, Hq * Dh) * (D ** -0.5)),
            "wo": _w((lambda *s: torch.randn(*s, dtype=torch.bfloat16) * 0.4)(Hq * Dh, D) * ((Hq * Dh) ** -0.5)),
        }
    _A_in = _A_setup()

    def _B_setup():
        B, S, D, Dff = 4, 1, 448, 1792
        return {
            "x": _w((lambda *s: torch.randn(*s, dtype=torch.bfloat16) * 0.05)(B, S, D)),
            "w1": _w((lambda *s: torch.randn(*s, dtype=torch.bfloat16) * 0.05)(D, Dff)),
            "w2": _w((lambda *s: torch.randn(*s, dtype=torch.bfloat16) * 0.05)(Dff, D)),
        }
    _B_in = _B_setup()

    return {
        "A_x": _A_in["x"],
        "A_k_cache": _A_in["k_cache"],
        "A_v_cache": _A_in["v_cache"],
        "A_wq": _A_in["wq"],
        "A_wo": _A_in["wo"],
        "B_x": _B_in["x"],
        "B_w1": _B_in["w1"],
        "B_w2": _B_in["w2"],
        "gate_w": _w((lambda *s: torch.randn(*s, dtype=torch.bfloat16) * 0.05)(448) * 16.0),
    }

def reference(A_x, A_k_cache, A_v_cache, A_wq, A_wo, B_x, B_w1, B_w2, gate_w):
    def _A_ref(x, k_cache, v_cache, wq, wo):
        B, Sq, D = x.shape
        Hq, Dh = 16, 256
        Hkv, Sk = k_cache.shape[1], k_cache.shape[2]
        W = min(4096, max(256, Sk // 4))
        rep = Hq // Hkv
        q = (lambda x, *d: x.permute(*d))((x @ wq).reshape(B, Sq, Hq, Dh), 0, 2, 1, 3)
        k = (lambda x, n, axis: torch.repeat_interleave(x, n, dim=axis))(k_cache[:, :, Sk - W:, :], rep, axis=1)
        v = (lambda x, n, axis: torch.repeat_interleave(x, n, dim=axis))(v_cache[:, :, Sk - W:, :], rep, axis=1)
        scores = torch.einsum("bhqd,bhkd->bhqk", q, k) * (Dh ** -0.5)
        p = _softmax(scores, axis=-1)
        o = torch.einsum("bhqk,bhkd->bhqd", p, v)
        return (lambda x, *d: x.permute(*d))(o, 0, 2, 1, 3).reshape(B, Sq, Hq * Dh) @ wo

    def _B_ref(x, w1, w2):
        h = torch.einsum("bsd,df->bsf", x, w1)
        zero = torch.zeros_like(h)
        h = torch.maximum(h, zero)
        return torch.einsum("bsf,fd->bsd", h, w2)

    x = A_x
    g = _sigmoid((x * gate_w).sum(-1, keepdims=True))
    a = _A_ref(x, A_k_cache, A_v_cache, A_wq, A_wo)
    b = _B_ref(x, B_w1, B_w2)
    return g * a + (1 - g) * b
```

```asm
; @launch grid=(256,1,1) block=(640,1,1) lds=163840
.amdgcn_target "amdgcn-amd-amdhsa--gfx950"
.text
.globl gated_mix__sliding_block_cached__dense_activation_relu__decode_kernel
.p2align 8
.type gated_mix__sliding_block_cached__dense_activation_relu__decode_kernel,@function
gated_mix__sliding_block_cached__dense_activation_relu__decode_kernel:
    s_cmp_ge_u32 s2, 256
    s_cbranch_scc1 L_exit
    s_load_dwordx16 s[16:31], s[0:1], 0
    s_load_dwordx8 s[32:39], s[0:1], 64
    v_lshrrev_b32 v1, 6, v0
    v_and_b32 v0, 63, v0
    v_mov_b32 v2, 159744
    v_readfirstlane_b32 s3, v1
    v_mov_b32 v5, 0
    v_lshl_add_u32 v7, v0, 2, v2
    s_cmp_lg_u32 s3, 9
    s_cbranch_scc1 L_noinit
    ds_write_b32 v7, v5 offset:2304
    ds_write_b32 v7, v5 offset:2560
    s_waitcnt lgkmcnt(0)
    L_noinit:
    s_and_b32 s4, s2, 7
    s_lshr_b32 s5, s2, 3
    s_and_b32 s6, s5, 3
    s_lshr_b32 s7, s5, 2
    s_mov_b32 s43, 0x400000
    s_cmp_eq_u32 s3, 1
    s_cbranch_scc1 L_aux
    s_cmp_gt_u32 s3, 1
    s_cbranch_scc1 L_comp
    s_setprio 3
    v_lshlrev_b32 v1, 4, v0
    v_lshrrev_b32 v3, 5, v0
    v_lshlrev_b32 v4, 4, v3
    v_xor_b32 v8, v1, v4
    v_lshlrev_b32 v4, 5, v3
    v_xor_b32 v16, v1, v4
    v_xor_b32 v9, 32, v8
    v_xor_b32 v10, 64, v8
    v_xor_b32 v11, 96, v8
    v_xor_b32 v12, 128, v8
    v_xor_b32 v13, 160, v8
    v_xor_b32 v14, 192, v8
    v_xor_b32 v15, 224, v8
    v_xor_b32 v17, 64, v16
    v_xor_b32 v18, 128, v16
    v_xor_b32 v19, 192, v16
    s_lshl_b32 s62, s6, 3
    s_add_u32 s62, s62, s4
    s_lshl_b32 s62, s62, 22
    s_lshl_b32 s63, s7, 17
    s_add_u32 s62, s62, s63
    s_add_u32 s62, s62, 0x300000
    s_mul_i32 s63, s5, 4096
    s_and_b32 s63, s63, 0x1ffff
    s_mov_b32 s64, 0
    s_mov_b32 s14, 0
    s_waitcnt lgkmcnt(0)
    s_mov_b32 s56, s18
    s_mov_b32 s57, s19
    s_mov_b32 s58, 134217728
    s_mov_b32 s59, 0x20000
    s_mov_b32 s8, s20
    s_mov_b32 s9, s21
    s_mov_b32 s10, 134217728
    s_mov_b32 s11, 0x20000
    s_barrier
    s_mov_b32 m0, 0
    s_mov_b32 s65, 0
    s_mov_b32 s67, s63
L_k1:
    s_add_u32 s66, s62, s67
    s_add_u32 s67, s67, 4096
    s_and_b32 s67, s67, 0x1ffff
    buffer_load_dwordx4 v8, s[56:59], s66 offen offset:0 nt lds
    buffer_load_dwordx4 v9, s[56:59], s66 offen offset:1024 nt lds
    buffer_load_dwordx4 v10, s[56:59], s66 offen offset:2048 nt lds
    buffer_load_dwordx4 v11, s[56:59], s66 offen offset:3072 nt lds
    s_add_u32 m0, m0, 4096
    s_add_u32 s64, s64, 4
    s_sub_u32 s15, s64, 32
    s_max_i32 s14, s14, s15
    v_mov_b32 v3, s14
    s_waitcnt vmcnt(32)
    ds_write_b32 v2, v3 offset:2576
    s_add_u32 s66, s62, s67
    s_add_u32 s67, s67, 4096
    s_and_b32 s67, s67, 0x1ffff
    buffer_load_dwordx4 v12, s[56:59], s66 offen offset:0 nt lds
    buffer_load_dwordx4 v13, s[56:59], s66 offen offset:1024 nt lds
    buffer_load_dwordx4 v14, s[56:59], s66 offen offset:2048 nt lds
    buffer_load_dwordx4 v15, s[56:59], s66 offen offset:3072 nt lds
    s_add_u32 m0, m0, 4096
    s_add_u32 s64, s64, 4
    s_sub_u32 s15, s64, 32
    s_max_i32 s14, s14, s15
    v_mov_b32 v3, s14
    s_waitcnt vmcnt(32)
    ds_write_b32 v2, v3 offset:2576
    s_add_u32 s65, s65, 1
    s_cmp_lt_u32 s65, 16
    s_cbranch_scc1 L_k1
    s_mov_b32 s48, s24
    s_mov_b32 s49, s25
    s_mov_b32 s50, 3670016
    s_mov_b32 s51, 0x20000
    s_mov_b32 s52, s30
    s_mov_b32 s53, s31
    s_mov_b32 s54, 1605632
    s_mov_b32 s55, 0x20000
    s_lshl_b32 s60, s4, 9
    s_lshl_b32 s61, s7, 5
    s_add_u32 s60, s60, s61
    s_mul_i32 s60, s60, 896
    s_lshl_b32 s61, s4, 3
    s_add_u32 s61, s61, s7
    s_mul_i32 s61, s61, 25088
    s_lshl_b32 s66, s6, 8
    s_add_u32 s60, s60, s66
    s_add_u32 s61, s61, s66
    v_lshrrev_b32 v3, 4, v0
    v_and_b32 v4, 15, v0
    v_mul_u32_u24 v1, 896, v3
    v_lshl_add_u32 v1, v4, 4, v1
    s_cmp_eq_u32 s6, 3
    s_cselect_b32 s66, 8, 16
    v_cmp_gt_u32 vcc, s66, v4
    v_mov_b32 v3, 0x8000000
    v_cndmask_b32 v1, v3, v1, vcc
    s_mov_b32 m0, 0
    s_mov_b32 s65, 0
    s_mov_b32 s67, s63
    s_mov_b32 s13, 16
L_v2:
    s_bitcmp1_b32 s65, 0
    s_cbranch_scc1 L_vc3
    s_lshl_b32 s66, s65, 1
    v_add_u32 v5, s66, v2
L_sp4:
    ds_read_b32 v4, v5 offset:2608
    s_sub_u32 s43, s43, 1
    s_cbranch_scc1 L_end
    s_waitcnt lgkmcnt(0)
    v_readfirstlane_b32 s42, v4
    s_cmp_ge_u32 s42, 1
    s_cbranch_scc0 L_sp4
L_vc3:
    s_add_u32 s66, s62, s67
    s_add_u32 s67, s67, 4096
    s_and_b32 s67, s67, 0x1ffff
    buffer_load_dwordx4 v16, s[8:11], s66 offen offset:0 nt lds
    buffer_load_dwordx4 v17, s[8:11], s66 offen offset:1024 nt lds
    buffer_load_dwordx4 v18, s[8:11], s66 offen offset:2048 nt lds
    buffer_load_dwordx4 v19, s[8:11], s66 offen offset:3072 nt lds
    s_add_u32 m0, m0, 4096
    s_add_u32 s64, s64, 4
    s_sub_u32 s15, s64, 32
    s_max_i32 s14, s14, s15
    v_mov_b32 v3, s14
    s_waitcnt vmcnt(32)
    ds_write_b32 v2, v3 offset:2576
    s_add_u32 s66, s62, s67
    s_add_u32 s67, s67, 4096
    s_and_b32 s67, s67, 0x1ffff
    buffer_load_dwordx4 v16, s[8:11], s66 offen offset:0 nt lds
    buffer_load_dwordx4 v17, s[8:11], s66 offen offset:1024 nt lds
    buffer_load_dwordx4 v18, s[8:11], s66 offen offset:2048 nt lds
    buffer_load_dwordx4 v19, s[8:11], s66 offen offset:3072 nt lds
    s_add_u32 m0, m0, 4096
    s_add_u32 s64, s64, 4
    s_sub_u32 s15, s64, 32
    s_max_i32 s14, s14, s15
    v_mov_b32 v3, s14
    s_waitcnt vmcnt(32)
    ds_write_b32 v2, v3 offset:2576
    s_add_u32 s65, s65, 1
    s_cmp_lt_u32 s65, s13
    s_cbranch_scc1 L_v2
L_sp5:
    ds_read_b32 v4, v2 offset:2600
    s_sub_u32 s43, s43, 1
    s_cbranch_scc1 L_end
    s_waitcnt lgkmcnt(0)
    v_readfirstlane_b32 s42, v4
    s_cmp_ge_u32 s42, 1
    s_cbranch_scc0 L_sp5
    s_mov_b32 m0, 131072
    s_mov_b32 s12, 2
L_ld6:
    buffer_load_dwordx4 v1, s[48:51], s60 offen nt lds
    s_add_u32 m0, m0, 1024
    s_add_u32 s60, s60, 3584
    buffer_load_dwordx4 v1, s[48:51], s60 offen nt lds
    s_add_u32 m0, m0, 1024
    s_add_u32 s60, s60, 3584
    buffer_load_dwordx4 v1, s[48:51], s60 offen nt lds
    s_add_u32 m0, m0, 1024
    s_add_u32 s60, s60, 3584
    buffer_load_dwordx4 v1, s[48:51], s60 offen nt lds
    s_add_u32 m0, m0, 1024
    s_add_u32 s60, s60, 3584
    s_add_u32 s64, s64, 4
    s_sub_u32 s15, s64, 32
    s_max_i32 s14, s14, s15
    v_mov_b32 v3, s14
    s_waitcnt vmcnt(32)
    ds_write_b32 v2, v3 offset:2576
    s_sub_u32 s12, s12, 1
    s_cmp_lg_u32 s12, 0
    s_cbranch_scc1 L_ld6
    s_add_u32 s60, s60, 200704
    s_mov_b32 s12, 2
L_ld7:
    buffer_load_dwordx4 v1, s[48:51], s60 offen nt lds
    s_add_u32 m0, m0, 1024
    s_add_u32 s60, s60, 3584
    buffer_load_dwordx4 v1, s[48:51], s60 offen nt lds
    s_add_u32 m0, m0, 1024
    s_add_u32 s60, s60, 3584
    buffer_load_dwordx4 v1, s[48:51], s60 offen nt lds
    s_add_u32 m0, m0, 1024
    s_add_u32 s60, s60, 3584
    buffer_load_dwordx4 v1, s[48:51], s60 offen nt lds
    s_add_u32 m0, m0, 1024
    s_add_u32 s60, s60, 3584
    s_add_u32 s64, s64, 4
    s_sub_u32 s15, s64, 32
    s_max_i32 s14, s14, s15
    v_mov_b32 v3, s14
    s_waitcnt vmcnt(32)
    ds_write_b32 v2, v3 offset:2576
    s_sub_u32 s12, s12, 1
    s_cmp_lg_u32 s12, 0
    s_cbranch_scc1 L_ld7
    s_mov_b32 s12, 2
L_ld8:
    buffer_load_dwordx4 v1, s[52:55], s61 offen nt lds
    s_add_u32 m0, m0, 1024
    s_add_u32 s61, s61, 3584
    buffer_load_dwordx4 v1, s[52:55], s61 offen nt lds
    s_add_u32 m0, m0, 1024
    s_add_u32 s61, s61, 3584
    buffer_load_dwordx4 v1, s[52:55], s61 offen nt lds
    s_add_u32 m0, m0, 1024
    s_add_u32 s61, s61, 3584
    buffer_load_dwordx4 v1, s[52:55], s61 offen nt lds
    s_add_u32 m0, m0, 1024
    s_add_u32 s61, s61, 3584
    s_add_u32 s64, s64, 4
    s_sub_u32 s15, s64, 32
    s_max_i32 s14, s14, s15
    v_mov_b32 v3, s14
    s_waitcnt vmcnt(32)
    ds_write_b32 v2, v3 offset:2576
    s_sub_u32 s12, s12, 1
    s_cmp_lg_u32 s12, 0
    s_cbranch_scc1 L_ld8
L_vdone:
    v_mov_b32 v3, 252
    s_waitcnt vmcnt(28)
    ds_write_b32 v2, v3 offset:2576
    v_mov_b32 v3, 256
    s_waitcnt vmcnt(24)
    ds_write_b32 v2, v3 offset:2576
    v_mov_b32 v3, 260
    s_waitcnt vmcnt(20)
    ds_write_b32 v2, v3 offset:2576
    v_mov_b32 v3, 264
    s_waitcnt vmcnt(16)
    ds_write_b32 v2, v3 offset:2576
    v_mov_b32 v3, 268
    s_waitcnt vmcnt(12)
    ds_write_b32 v2, v3 offset:2576
    v_mov_b32 v3, 272
    s_waitcnt vmcnt(8)
    ds_write_b32 v2, v3 offset:2576
    v_mov_b32 v3, 276
    s_waitcnt vmcnt(4)
    ds_write_b32 v2, v3 offset:2576
    v_mov_b32 v3, 280
    s_waitcnt vmcnt(0)
    ds_write_b32 v2, v3 offset:2576
    s_branch L_end
L_aux:
    s_setprio 2
    v_and_b32 v3, 3, v0
    v_lshrrev_b32 v4, 4, v0
    v_mul_u32_u24 v5, 896, v3
    v_lshl_add_u32 v5, v4, 4, v5
    v_lshrrev_b32 v6, 3, v0
    v_and_b32 v7, 3, v6
    v_lshlrev_b32 v7, 1, v7
    v_and_b32 v8, 7, v0
    v_xor_b32 v7, v7, v8
    v_lshlrev_b32 v7, 4, v7
    v_lshlrev_b32 v66, 4, v0
    s_and_b32 s60, s5, 7
    s_lshr_b32 s61, s5, 3
    s_mul_i32 s62, s4, 7
    s_add_u32 s62, s62, s5
    s_sub_u32 s62, s62, 16
    s_lshr_b32 s63, s62, 1
    s_and_b32 s62, s62, 1
    s_lshl_b32 s64, s4, 3
    s_add_u32 s64, s64, s60
    s_cmp_lt_u32 s5, 16
    s_cselect_b32 s61, s61, s62
    s_cselect_b32 s63, s64, s63
    s_mov_b32 s62, 3584
    s_cselect_b32 s62, 0x2000, s62
    s_cselect_b32 s65, 16, 15
    s_mul_i32 s60, s61, s62
    s_mul_i32 s60, s60, 224
    s_lshl_b32 s64, s63, 7
    s_add_u32 s60, s60, s64
    v_mul_lo_u32 v140, v6, s62
    v_add_u32 v140, v140, v7
    v_xor_b32 v141, 32, v140
    s_mov_b32 m0, 131072
    s_mov_b32 s12, 14
    s_waitcnt lgkmcnt(0)
    s_load_dwordx2 s[40:41], s[38:39], 0
    s_mov_b32 s48, s22
    s_mov_b32 s49, s23
    s_mov_b32 s50, 3670016
    s_mov_b32 s51, 0x20000
    s_mov_b32 s56, s28
    s_mov_b32 s57, s29
    s_mov_b32 s58, 1605632
    s_mov_b32 s59, 0x20000
    s_cmp_ge_u32 s5, 23
    s_cbranch_scc1 L_pl
    s_cmp_ge_u32 s5, 16
    s_cbranch_scc1 L_pf
L_pq:
    buffer_load_dwordx4 v140, s[48:51], s60 offen nt lds
    s_add_u32 m0, m0, 1024
    s_add_u32 s60, s60, 65536
    buffer_load_dwordx4 v141, s[48:51], s60 offen nt lds
    s_add_u32 m0, m0, 1024
    s_add_u32 s60, s60, 65536
    s_sub_u32 s12, s12, 1
    s_cmp_lg_u32 s12, 0
    s_cbranch_scc1 L_pq
    s_branch L_pl
L_pf:
    buffer_load_dwordx4 v140, s[56:59], s60 offen nt lds
    s_add_u32 m0, m0, 1024
    s_add_u32 s60, s60, 28672
    buffer_load_dwordx4 v141, s[56:59], s60 offen nt lds
    s_add_u32 m0, m0, 1024
    s_add_u32 s60, s60, 28672
    s_sub_u32 s12, s12, 1
    s_cmp_lg_u32 s12, 0
    s_cbranch_scc1 L_pf
L_pl:
    s_mov_b32 s52, s16
    s_mov_b32 s53, s17
    s_mov_b32 s54, 3584
    s_mov_b32 s55, 0x20000
    s_mov_b32 s8, s32
    s_mov_b32 s9, s33
    s_mov_b32 s10, 896
    s_mov_b32 s11, 0x20000
    s_mov_b32 s44, s38
    s_mov_b32 s45, s39
    s_mov_b32 s46, 2490368
    s_mov_b32 s47, 0x20000
    s_mul_i32 s66, s61, 448
    s_sub_u32 s67, 448, s66
    buffer_load_dwordx4 v[8:11], v5, s[52:55], s66 offen offset:0
    buffer_load_dwordx4 v[12:15], v5, s[52:55], s66 offen offset:64
    buffer_load_dwordx4 v[16:19], v5, s[52:55], s66 offen offset:128
    buffer_load_dwordx4 v[20:23], v5, s[52:55], s66 offen offset:192
    buffer_load_dwordx4 v[24:27], v5, s[52:55], s66 offen offset:256
    buffer_load_dwordx4 v[28:31], v5, s[52:55], s66 offen offset:320
    buffer_load_dwordx4 v[32:35], v5, s[52:55], s66 offen offset:384
    buffer_load_dwordx4 v[36:39], v5, s[52:55], s67 offen offset:0
    buffer_load_dwordx4 v[40:43], v5, s[52:55], s67 offen offset:64
    buffer_load_dwordx4 v[44:47], v5, s[52:55], s67 offen offset:128
    buffer_load_dwordx4 v[48:51], v5, s[52:55], s67 offen offset:192
    buffer_load_dwordx4 v[52:55], v5, s[52:55], s67 offen offset:256
    buffer_load_dwordx4 v[56:59], v5, s[52:55], s67 offen offset:320
    buffer_load_dwordx4 v[60:63], v5, s[52:55], s67 offen offset:384
    s_mov_b32 m0, 162560
    v_lshl_add_u32 v68, v4, 4, v2
    buffer_load_dwordx4 v66, s[8:11], 0 offen lds
    s_barrier
    v_add_u32 v69, s67, v68
    v_add_u32 v68, s66, v68
    v_bfe_u32 v6, v0, 2, 2
    v_and_b32 v7, 1, v4
    v_xor_b32 v7, v7, v6
    v_lshlrev_b32 v7, 5, v7
    v_lshl_add_u32 v7, v6, 7, v7
    v_lshl_add_u32 v7, v4, 10, v7
    v_lshl_add_u32 v7, v3, 3, v7
    v_add_u32 v142, 131072, v7
    v_xor_b32 v143, 32, v142
    v_xor_b32 v144, 64, v142
    v_xor_b32 v145, 0x60, v142
    v_lshlrev_b32 v146, s65, v3
    v_lshl_add_u32 v146, v6, 6, v146
    v_lshl_add_u32 v146, v4, 4, v146
    v_cmp_eq_u32 s[14:15], 1, v6
    v_cmp_eq_u32 s[90:91], 2, v6
    v_cmp_eq_u32 s[92:93], 3, v6
    s_lshl_b32 s60, s4, 13
    s_lshl_b32 s64, s61, 12
    s_add_u32 s60, s60, s64
    s_and_b32 s64, s63, 7
    s_lshl_b32 s64, s64, 9
    s_add_u32 s60, s60, s64
    s_add_u32 s60, s60, 2097152
    s_lshl_b32 s64, s61, 14
    s_lshl_b32 s63, s63, 9
    s_add_u32 s64, s64, s63
    s_add_u32 s64, s64, 2359296
    s_cmp_lt_u32 s5, 16
    s_cselect_b32 s60, s60, s64
    s_waitcnt vmcnt(0) lgkmcnt(0)
    s_add_u32 s40, s40, 1
    s_addc_u32 s41, s41, 0
    v_mov_b32 v138, s40
    v_mov_b32 v139, s41
    v_mov_b32 v85, 1
    s_cmp_ge_u32 s5, 23
    s_cbranch_scc1 L_nop
    ds_read_b64_tr_b16 v[80:81], v142 offset:0
    ds_read_b64_tr_b16 v[82:83], v142 offset:512
    ds_read_b64_tr_b16 v[84:85], v143 offset:0
    ds_read_b64_tr_b16 v[86:87], v143 offset:512
    ds_read_b64_tr_b16 v[88:89], v142 offset:4096
    ds_read_b64_tr_b16 v[90:91], v142 offset:4608
    ds_read_b64_tr_b16 v[92:93], v143 offset:4096
    ds_read_b64_tr_b16 v[94:95], v143 offset:4608
    ds_read_b64_tr_b16 v[96:97], v142 offset:8192
    ds_read_b64_tr_b16 v[98:99], v142 offset:8704
    ds_read_b64_tr_b16 v[100:101], v143 offset:8192
    ds_read_b64_tr_b16 v[102:103], v143 offset:8704
    ds_read_b64_tr_b16 v[104:105], v142 offset:12288
    ds_read_b64_tr_b16 v[106:107], v142 offset:12800
    ds_read_b64_tr_b16 v[108:109], v143 offset:12288
    ds_read_b64_tr_b16 v[110:111], v143 offset:12800
    ds_read_b64_tr_b16 v[112:113], v142 offset:16384
    ds_read_b64_tr_b16 v[114:115], v142 offset:16896
    ds_read_b64_tr_b16 v[116:117], v143 offset:16384
    ds_read_b64_tr_b16 v[118:119], v143 offset:16896
    ds_read_b64_tr_b16 v[120:121], v142 offset:20480
    ds_read_b64_tr_b16 v[122:123], v142 offset:20992
    ds_read_b64_tr_b16 v[124:125], v143 offset:20480
    ds_read_b64_tr_b16 v[126:127], v143 offset:20992
    ds_read_b64_tr_b16 v[128:129], v142 offset:24576
    ds_read_b64_tr_b16 v[130:131], v142 offset:25088
    ds_read_b64_tr_b16 v[132:133], v143 offset:24576
    ds_read_b64_tr_b16 v[134:135], v143 offset:25088
    s_waitcnt lgkmcnt(12)
    v_mfma_f32_16x16x32_bf16 v[148:151], v[80:83], v[8:11], 0
    v_mfma_f32_16x16x32_bf16 v[152:155], v[84:87], v[8:11], 0
    v_mfma_f32_16x16x32_bf16 v[148:151], v[88:91], v[12:15], v[148:151]
    v_mfma_f32_16x16x32_bf16 v[152:155], v[92:95], v[12:15], v[152:155]
    v_mfma_f32_16x16x32_bf16 v[148:151], v[96:99], v[16:19], v[148:151]
    v_mfma_f32_16x16x32_bf16 v[152:155], v[100:103], v[16:19], v[152:155]
    v_mfma_f32_16x16x32_bf16 v[148:151], v[104:107], v[20:23], v[148:151]
    v_mfma_f32_16x16x32_bf16 v[152:155], v[108:111], v[20:23], v[152:155]
    s_waitcnt lgkmcnt(8)
    v_mfma_f32_16x16x32_bf16 v[148:151], v[112:115], v[24:27], v[148:151]
    v_mfma_f32_16x16x32_bf16 v[152:155], v[116:119], v[24:27], v[152:155]
    s_waitcnt lgkmcnt(4)
    v_mfma_f32_16x16x32_bf16 v[148:151], v[120:123], v[28:31], v[148:151]
    v_mfma_f32_16x16x32_bf16 v[152:155], v[124:127], v[28:31], v[152:155]
    s_waitcnt lgkmcnt(0)
    v_mfma_f32_16x16x32_bf16 v[148:151], v[128:131], v[32:35], v[148:151]
    v_mfma_f32_16x16x32_bf16 v[152:155], v[132:135], v[32:35], v[152:155]
    ds_read_b64_tr_b16 v[80:81], v144 offset:0
    ds_read_b64_tr_b16 v[82:83], v144 offset:512
    ds_read_b64_tr_b16 v[84:85], v145 offset:0
    ds_read_b64_tr_b16 v[86:87], v145 offset:512
    ds_read_b64_tr_b16 v[88:89], v144 offset:4096
    ds_read_b64_tr_b16 v[90:91], v144 offset:4608
    ds_read_b64_tr_b16 v[92:93], v145 offset:4096
    ds_read_b64_tr_b16 v[94:95], v145 offset:4608
    ds_read_b64_tr_b16 v[96:97], v144 offset:8192
    ds_read_b64_tr_b16 v[98:99], v144 offset:8704
    ds_read_b64_tr_b16 v[100:101], v145 offset:8192
    ds_read_b64_tr_b16 v[102:103], v145 offset:8704
    ds_read_b64_tr_b16 v[104:105], v144 offset:12288
    ds_read_b64_tr_b16 v[106:107], v144 offset:12800
    ds_read_b64_tr_b16 v[108:109], v145 offset:12288
    ds_read_b64_tr_b16 v[110:111], v145 offset:12800
    ds_read_b64_tr_b16 v[112:113], v144 offset:16384
    ds_read_b64_tr_b16 v[114:115], v144 offset:16896
    ds_read_b64_tr_b16 v[116:117], v145 offset:16384
    ds_read_b64_tr_b16 v[118:119], v145 offset:16896
    ds_read_b64_tr_b16 v[120:121], v144 offset:20480
    ds_read_b64_tr_b16 v[122:123], v144 offset:20992
    ds_read_b64_tr_b16 v[124:125], v145 offset:20480
    ds_read_b64_tr_b16 v[126:127], v145 offset:20992
    ds_read_b64_tr_b16 v[128:129], v144 offset:24576
    ds_read_b64_tr_b16 v[130:131], v144 offset:25088
    ds_read_b64_tr_b16 v[132:133], v145 offset:24576
    ds_read_b64_tr_b16 v[134:135], v145 offset:25088
    s_waitcnt lgkmcnt(12)
    v_mfma_f32_16x16x32_bf16 v[70:73], v[80:83], v[8:11], 0
    v_mfma_f32_16x16x32_bf16 v[74:77], v[84:87], v[8:11], 0
    v_mfma_f32_16x16x32_bf16 v[70:73], v[88:91], v[12:15], v[70:73]
    v_mfma_f32_16x16x32_bf16 v[74:77], v[92:95], v[12:15], v[74:77]
    v_mfma_f32_16x16x32_bf16 v[70:73], v[96:99], v[16:19], v[70:73]
    v_mfma_f32_16x16x32_bf16 v[74:77], v[100:103], v[16:19], v[74:77]
    v_mfma_f32_16x16x32_bf16 v[70:73], v[104:107], v[20:23], v[70:73]
    v_mfma_f32_16x16x32_bf16 v[74:77], v[108:111], v[20:23], v[74:77]
    s_waitcnt lgkmcnt(8)
    v_mfma_f32_16x16x32_bf16 v[70:73], v[112:115], v[24:27], v[70:73]
    v_mfma_f32_16x16x32_bf16 v[74:77], v[116:119], v[24:27], v[74:77]
    s_waitcnt lgkmcnt(4)
    v_mfma_f32_16x16x32_bf16 v[70:73], v[120:123], v[28:31], v[70:73]
    v_mfma_f32_16x16x32_bf16 v[74:77], v[124:127], v[28:31], v[74:77]
    s_waitcnt lgkmcnt(0)
    v_mfma_f32_16x16x32_bf16 v[70:73], v[128:131], v[32:35], v[70:73]
    v_mfma_f32_16x16x32_bf16 v[74:77], v[132:135], v[32:35], v[74:77]
    v_mov_b32 v85, 1
    ds_write_b32 v2, v85 offset:2600
    s_nop 4
    v_cndmask_b32 v148, v148, v152, s[14:15]
    v_cndmask_b32 v149, v149, v153, s[14:15]
    v_cndmask_b32 v150, v150, v154, s[14:15]
    v_cndmask_b32 v151, v151, v155, s[14:15]
    v_cndmask_b32 v148, v148, v70, s[90:91]
    v_cndmask_b32 v149, v149, v71, s[90:91]
    v_cndmask_b32 v150, v150, v72, s[90:91]
    v_cndmask_b32 v151, v151, v73, s[90:91]
    v_cndmask_b32 v148, v148, v74, s[92:93]
    v_cndmask_b32 v149, v149, v75, s[92:93]
    v_cndmask_b32 v150, v150, v76, s[92:93]
    v_cndmask_b32 v151, v151, v77, s[92:93]
    v_mov_b32 v136, v150
    v_mov_b32 v137, v151
    v_mov_b32 v150, s40
    v_mov_b32 v151, s41
    buffer_store_dwordx4 v[148:151], v146, s[44:47], s60 offen sc1
    buffer_store_dwordx4 v[136:139], v146, s[44:47], s60 offen offset:256 sc1
    L_nop:
    ds_write_b32 v2, v85 offset:2600
    ds_read_b128 v[80:83], v68 offset:2816
    ds_read_b128 v[84:87], v68 offset:2880
    ds_read_b128 v[88:91], v68 offset:2944
    ds_read_b128 v[92:95], v68 offset:3008
    ds_read_b128 v[96:99], v68 offset:3072
    ds_read_b128 v[100:103], v68 offset:3136
    ds_read_b128 v[104:107], v68 offset:3200
    ds_read_b128 v[108:111], v69 offset:2816
    ds_read_b128 v[112:115], v69 offset:2880
    ds_read_b128 v[116:119], v69 offset:2944
    ds_read_b128 v[120:123], v69 offset:3008
    ds_read_b128 v[124:127], v69 offset:3072
    ds_read_b128 v[128:131], v69 offset:3136
    ds_read_b128 v[132:135], v69 offset:3200
    s_waitcnt lgkmcnt(0)
    v_mfma_f32_16x16x32_bf16 v[76:79], v[80:83], v[8:11], 0
    v_mfma_f32_16x16x32_bf16 v[76:79], v[84:87], v[12:15], v[76:79]
    v_mfma_f32_16x16x32_bf16 v[76:79], v[88:91], v[16:19], v[76:79]
    v_mfma_f32_16x16x32_bf16 v[76:79], v[92:95], v[20:23], v[76:79]
    v_mfma_f32_16x16x32_bf16 v[76:79], v[96:99], v[24:27], v[76:79]
    v_mfma_f32_16x16x32_bf16 v[76:79], v[100:103], v[28:31], v[76:79]
    v_mfma_f32_16x16x32_bf16 v[76:79], v[104:107], v[32:35], v[76:79]
    v_mfma_f32_16x16x32_bf16 v[76:79], v[108:111], v[36:39], v[76:79]
    v_mfma_f32_16x16x32_bf16 v[76:79], v[112:115], v[40:43], v[76:79]
    v_mfma_f32_16x16x32_bf16 v[76:79], v[116:119], v[44:47], v[76:79]
    v_mfma_f32_16x16x32_bf16 v[76:79], v[120:123], v[48:51], v[76:79]
    v_mfma_f32_16x16x32_bf16 v[76:79], v[124:127], v[52:55], v[76:79]
    v_mfma_f32_16x16x32_bf16 v[76:79], v[128:131], v[56:59], v[76:79]
    v_mfma_f32_16x16x32_bf16 v[76:79], v[132:135], v[60:63], v[76:79]
    v_lshl_add_u32 v82, v3, 2, v2
    s_nop 6
    v_mov_b32 v80, v76
    v_cvt_pk_bf16_f32 v80, v80, v80
    v_lshlrev_b32 v80, 16, v80
    v_mul_f32 v80, 0xbfb8aa3b, v80
    v_exp_f32 v80, v80
    s_nop 0
    v_add_f32 v80, 1.0, v80
    v_rcp_f32 v80, v80
    s_nop 0
    v_cvt_pk_bf16_f32 v80, v80, v80
    v_lshlrev_b32 v80, 16, v80
    v_sub_f32 v81, 1.0, v80
    v_cvt_pk_bf16_f32 v81, v81, v81
    v_lshlrev_b32 v81, 16, v81
    ds_write_b32 v82, v81 offset:2256
    ds_write_b32 v82, v80 offset:2656
    ds_write_b64 v2, v[138:139] offset:2272
    s_lshl_b32 s60, s6, 3
    s_add_u32 s60, s60, s4
    s_lshl_b32 s62, s4, 10
    s_add_u32 s62, s62, 163840
    s_lshl_b32 s60, s60, 13
    s_add_u32 s60, s60, 2097152
    s_add_u32 s63, s60, 4096
    s_lshl_b32 s61, s4, 3
    s_add_u32 s61, s61, s7
    s_mul_i32 s61, s61, 7
    v_bfe_u32 v82, v0, 1, 3
    v_min_u32 v82, 6, v82
    v_add_u32 v83, s61, v82
    v_and_b32 v84, 15, v83
    v_lshrrev_b32 v83, 4, v83
    v_lshlrev_b32 v83, 9, v83
    v_lshl_add_u32 v83, v84, 4, v83
    v_and_b32 v84, 1, v0
    v_lshl_add_u32 v83, v84, 8, v83
    v_lshl_add_u32 v83, v4, 15, v83
    v_lshl_add_u32 v82, v82, 3, v2
    v_lshl_add_u32 v82, v4, 6, v82
    v_lshl_add_u32 v82, v84, 2, v82
    v_and_b32 v84, 15, v0
    v_lshl_add_u32 v84, v84, 3, v2
    v_and_b32 v85, 1, v4
    v_lshl_add_u32 v84, v85, 2, v84
    v_lshrrev_b32 v85, 5, v0
    v_lshl_add_u32 v84, v85, 7, v84
    v_mov_b32 v85, 1
    s_mov_b32 s61, 2359296
    s_mov_b32 s59, 2375680
L_sp9:
    ds_read_b32 v86, v2 offset:2576
    s_sub_u32 s43, s43, 1
    s_cbranch_scc1 L_end
    s_sleep 2
    s_waitcnt lgkmcnt(0)
    v_readfirstlane_b32 s42, v86
    s_cmp_ge_u32 s42, 72
    s_cbranch_scc0 L_sp9
L_pq10:
    buffer_load_dwordx4 v[88:91], v66, s[44:47], s60 offen offset:0 sc1
    buffer_load_dwordx4 v[92:95], v66, s[44:47], s60 offen offset:1024 sc1
    buffer_load_dwordx4 v[96:99], v66, s[44:47], s60 offen offset:2048 sc1
    buffer_load_dwordx4 v[100:103], v66, s[44:47], s60 offen offset:3072 sc1
    buffer_load_dwordx4 v[104:107], v66, s[44:47], s63 offen offset:0 sc1
    buffer_load_dwordx4 v[108:111], v66, s[44:47], s63 offen offset:1024 sc1
    buffer_load_dwordx4 v[112:115], v66, s[44:47], s63 offen offset:2048 sc1
    buffer_load_dwordx4 v[116:119], v66, s[44:47], s63 offen offset:3072 sc1
    buffer_load_dwordx4 v[120:123], v83, s[44:47], s61 offen sc1
    buffer_load_dwordx4 v[124:127], v83, s[44:47], s59 offen sc1
    s_sub_u32 s43, s43, 16
    s_cbranch_scc1 L_end
    s_sleep 2
    s_mov_b64 s[64:65], 0
    s_waitcnt vmcnt(9)
    v_cmp_ne_u64 vcc, s[40:41], v[90:91]
    s_or_b64 s[64:65], s[64:65], vcc
    s_waitcnt vmcnt(8)
    v_cmp_ne_u64 vcc, s[40:41], v[94:95]
    s_or_b64 s[64:65], s[64:65], vcc
    s_waitcnt vmcnt(7)
    v_cmp_ne_u64 vcc, s[40:41], v[98:99]
    s_or_b64 s[64:65], s[64:65], vcc
    s_waitcnt vmcnt(6)
    v_cmp_ne_u64 vcc, s[40:41], v[102:103]
    s_or_b64 s[64:65], s[64:65], vcc
    s_waitcnt vmcnt(5)
    v_cmp_ne_u64 vcc, s[40:41], v[106:107]
    s_or_b64 s[64:65], s[64:65], vcc
    s_waitcnt vmcnt(4)
    v_cmp_ne_u64 vcc, s[40:41], v[110:111]
    s_or_b64 s[64:65], s[64:65], vcc
    s_waitcnt vmcnt(3)
    v_cmp_ne_u64 vcc, s[40:41], v[114:115]
    s_or_b64 s[64:65], s[64:65], vcc
    s_waitcnt vmcnt(2)
    v_cmp_ne_u64 vcc, s[40:41], v[118:119]
    s_or_b64 s[64:65], s[64:65], vcc
    s_cbranch_scc1 L_pq10
    v_add_f32 v88, v88, v104
    v_add_f32 v89, v89, v105
    v_cvt_pk_bf16_f32 v88, v88, v89
    ds_write_b32 v84, v88 offset:0
    v_add_f32 v92, v92, v108
    v_add_f32 v93, v93, v109
    v_cvt_pk_bf16_f32 v92, v92, v93
    ds_write_b32 v84, v92 offset:256
    v_add_f32 v96, v96, v112
    v_add_f32 v97, v97, v113
    v_cvt_pk_bf16_f32 v96, v96, v97
    ds_write_b32 v84, v96 offset:528
    v_add_f32 v100, v100, v116
    v_add_f32 v101, v101, v117
    v_cvt_pk_bf16_f32 v100, v100, v101
    ds_write_b32 v84, v100 offset:784
    s_waitcnt lgkmcnt(0)
    ds_write_b32 v2, v85 offset:2584
    s_branch L_hc
    L_hp:
    buffer_load_dwordx4 v[120:123], v83, s[44:47], s61 offen sc1
    buffer_load_dwordx4 v[124:127], v83, s[44:47], s59 offen sc1
    s_sub_u32 s43, s43, 16
    s_cbranch_scc1 L_end
    s_sleep 2
    L_hc:
    s_waitcnt vmcnt(0)
    v_cmp_ne_u64 vcc, s[40:41], v[122:123]
    v_cmp_ne_u64 s[66:67], s[40:41], v[126:127]
    s_or_b64 vcc, vcc, s[66:67]
    s_cbranch_vccnz L_hp
    v_add_f32 v120, v120, v124
    v_add_f32 v121, v121, v125
    v_max_f32 v120, 0, v120
    v_max_f32 v121, 0, v121
    v_cvt_pk_bf16_f32 v120, v120, v121
    ds_write_b32 v82, v120 offset:2304
L_sp11:
    ds_read_b32 v86, v2 offset:2592
    s_sub_u32 s43, s43, 1
    s_cbranch_scc1 L_end
    s_sleep 1
    s_waitcnt lgkmcnt(0)
    v_readfirstlane_b32 s42, v86
    s_cmp_ge_u32 s42, 8
    s_cbranch_scc0 L_sp11
    v_and_b32 v86, 15, v0
    v_lshl_add_u32 v87, v86, 2, v2
    v_and_b32 v88, 1, v0
    v_lshl_add_u32 v88, v88, 2, v2
    ds_read_b32 v93, v87 offset:2176
    ds_read_b32 v92, v88 offset:2240
    v_mov_b32 v94, s40
    v_mov_b32 v95, s41
    v_lshlrev_b32 v87, 4, v86
    s_lshl_b32 s63, s7, 5
    s_add_u32 s63, s63, s62
    s_lshl_b32 s64, s6, 8
    s_add_u32 s63, s63, s64
    v_lshl_add_u32 v101, v4, 2, v2
    ds_read_b32 v101, v101 offset:2656
    v_lshrrev_b32 v102, 1, v0
    v_lshl_add_u32 v102, v102, 2, v2
    v_and_b32 v103, 1, v0
    v_lshl_add_u32 v102, v103, 7, v102
    v_lshrrev_b32 v104, 1, v0
    v_lshlrev_b32 v104, 5, v104
    v_lshl_add_u32 v104, v103, 4, v104
    s_waitcnt lgkmcnt(0)
    v_add_f32_dpp v93, v93, v93 row_ror:8 row_mask:0xf bank_mask:0xf
    s_nop 1
    v_add_f32_dpp v93, v93, v93 row_ror:4 row_mask:0xf bank_mask:0xf
    s_nop 1
    v_add_f32_dpp v93, v93, v93 row_ror:2 row_mask:0xf bank_mask:0xf
    s_nop 1
    s_mov_b64 exec, 3
    buffer_store_dwordx4 v[92:95], v87, s[44:47], s63 offen sc1
    s_mov_b64 exec, -1
L_sp12:
    ds_read_b32 v86, v2 offset:2576
    s_sub_u32 s43, s43, 1
    s_cbranch_scc1 L_end
    s_sleep 2
    s_waitcnt lgkmcnt(0)
    v_readfirstlane_b32 s42, v86
    s_cmp_ge_u32 s42, 248
    s_cbranch_scc0 L_sp12
    s_setprio 3
L_ps13:
    buffer_load_dwordx4 v[96:99], v104, s[44:47], s62 offen sc1
    s_sub_u32 s43, s43, 16
    s_cbranch_scc1 L_end
    s_sleep 2
    s_waitcnt vmcnt(0)
    v_cmp_ne_u64 vcc, s[40:41], v[98:99]
    s_cbranch_vccnz L_ps13
    v_mov_b32 v100, v96
    s_mov_b32 s64, 0x3db8aa3b
    s_nop 0
    v_max_f32_dpp v100, v100, v100 row_ror:8 row_mask:0xf bank_mask:0xf
    s_nop 1
    v_max_f32_dpp v100, v100, v100 row_ror:4 row_mask:0xf bank_mask:0xf
    s_nop 1
    v_max_f32_dpp v100, v100, v100 row_ror:2 row_mask:0xf bank_mask:0xf
    s_nop 1
    v_sub_f32 v96, v96, v100
    v_mul_f32 v96, s64, v96
    v_exp_f32 v96, v96
    s_nop 0
    v_mul_f32 v92, v101, v96
    v_mul_f32 v96, v96, v97
    s_nop 0
    v_add_f32_dpp v96, v96, v96 row_ror:8 row_mask:0xf bank_mask:0xf
    s_nop 1
    v_add_f32_dpp v96, v96, v96 row_ror:4 row_mask:0xf bank_mask:0xf
    s_nop 1
    v_add_f32_dpp v96, v96, v96 row_ror:2 row_mask:0xf bank_mask:0xf
    s_nop 1
    v_rcp_f32 v96, v96
    s_nop 0
    v_mul_f32 v92, v92, v96
    ds_write_b32 v102, v92 offset:3840
    s_waitcnt lgkmcnt(0)
    ds_write_b32 v2, v85 offset:2596
    s_cmp_lt_u32 s4, 6
    s_cselect_b32 s62, 32, 16
    s_cmp_ge_u32 s5, s62
    s_cbranch_scc1 L_end
    s_lshl_b32 s62, s4, 17
    s_lshl_b32 s63, s5, 6
    s_add_u32 s62, s62, s63
    s_add_u32 s62, s62, 1048576
    s_add_u32 s63, s62, 0x8000
    s_add_u32 s64, s62, 0x10000
    s_add_u32 s65, s62, 0x18000
    v_lshrrev_b32 v86, 2, v0
    v_lshlrev_b32 v86, 11, v86
    v_lshl_add_u32 v86, v3, 4, v86
    s_and_b32 s60, s2, 1
    s_mul_i32 s60, s60, 1792
    s_lshr_b32 s66, s4, 1
    s_lshl_b32 s66, s66, 8
    s_add_u32 s60, s60, s66
    s_lshl_b32 s66, s5, 3
    s_add_u32 s60, s60, s66
    v_lshlrev_b32 v87, 1, v3
    s_mov_b32 s48, s34
    s_mov_b32 s49, s35
    s_mov_b32 s50, 3584
    s_mov_b32 s51, 0x20000
L_sp14:
    ds_read_b32 v85, v2 offset:2640
    s_sub_u32 s43, s43, 1
    s_cbranch_scc1 L_end
    s_sleep 1
    s_waitcnt lgkmcnt(0)
    v_readfirstlane_b32 s42, v85
    s_cmp_ge_u32 s42, 8
    s_cbranch_scc0 L_sp14
    s_mov_b64 s[52:53], -1
    s_mov_b64 s[54:55], -1
    s_mov_b64 s[56:57], -1
    s_mov_b64 s[58:59], -1
L_pf15:
    s_mov_b64 exec, s[52:53]
    buffer_load_dwordx4 v[88:91], v86, s[44:47], s62 offen sc1
    s_mov_b64 exec, s[54:55]
    buffer_load_dwordx4 v[92:95], v86, s[44:47], s63 offen sc1
    s_mov_b64 exec, s[56:57]
    buffer_load_dwordx4 v[96:99], v86, s[44:47], s64 offen sc1
    s_mov_b64 exec, s[58:59]
    buffer_load_dwordx4 v[100:103], v86, s[44:47], s65 offen sc1
    s_mov_b64 exec, -1
    s_sub_u32 s43, s43, 16
    s_cbranch_scc1 L_end
    s_waitcnt vmcnt(0)
    v_cmp_ne_u64 s[52:53], s[40:41], v[90:91]
    v_cmp_ne_u64 s[54:55], s[40:41], v[94:95]
    v_cmp_ne_u64 s[56:57], s[40:41], v[98:99]
    v_cmp_ne_u64 s[58:59], s[40:41], v[102:103]
    s_or_b64 vcc, s[52:53], s[54:55]
    s_or_b64 s[66:67], s[58:59], s[56:57]
    s_or_b64 vcc, vcc, s[66:67]
    s_cbranch_vccz L_fd
L_sp16:
    ds_read_b32 v85, v2 offset:2640
    s_sub_u32 s43, s43, 1
    s_cbranch_scc1 L_end
    s_sleep 1
    s_waitcnt lgkmcnt(0)
    v_readfirstlane_b32 s42, v85
    s_cmp_ge_u32 s42, 8
    s_cbranch_scc0 L_sp16
    s_branch L_pf15
    L_fd:
    v_add_f32 v88, v88, v92
    v_add_f32 v89, v89, v93
    v_add_f32 v96, v96, v100
    v_add_f32 v97, v97, v101
    v_add_f32 v88, v88, v96
    v_add_f32 v89, v89, v97
    s_nop 0
    v_add_f32_dpp v88, v88, v88 row_ror:4 row_mask:0xf bank_mask:0xf
    v_add_f32_dpp v89, v89, v89 row_ror:4 row_mask:0xf bank_mask:0xf
    s_nop 0
    v_add_f32_dpp v88, v88, v88 row_ror:8 row_mask:0xf bank_mask:0xf
    v_add_f32_dpp v89, v89, v89 row_ror:8 row_mask:0xf bank_mask:0xf
    v_mov_b32 v90, v88
    v_mov_b32 v91, v89
    s_nop 0
    v_permlane16_swap_b32 v88, v90
    v_permlane16_swap_b32 v89, v91
    v_add_f32 v88, v88, v90
    v_add_f32 v89, v89, v91
    v_mov_b32 v90, v88
    v_mov_b32 v91, v89
    s_nop 0
    v_permlane32_swap_b32 v88, v90
    v_permlane32_swap_b32 v89, v91
    v_add_f32 v88, v88, v90
    v_add_f32 v89, v89, v91
    v_cvt_pk_bf16_f32 v88, v88, v89
    s_mov_b64 exec, 15
    buffer_store_short v88, v87, s[48:51], s60 offen
    buffer_store_short_d16_hi v88, v87, s[48:51], s60 offen offset:896
    s_cmp_lg_u32 s2, 0
    s_cbranch_scc1 L_end
    s_mov_b64 exec, 1
    v_mov_b32 v86, 0
    v_mov_b32 v90, s40
    v_mov_b32 v91, s41
    buffer_store_dwordx2 v[90:91], v86, s[44:47], 0 offen
    s_branch L_end
L_comp:
    s_sub_u32 s60, s3, 2
    v_and_b32 v3, 15, v0
    v_lshrrev_b32 v4, 4, v0
    v_mov_b32 v1, 1
    v_lshrrev_b32 v8, 2, v0
    v_and_b32 v9, 3, v0
    v_and_b32 v10, 3, v8
    v_lshl_add_u32 v10, v4, 3, v10
    v_lshlrev_b32 v10, 8, v10
    v_lshl_add_u32 v10, v9, 3, v10
    s_lshr_b32 s61, s60, 1
    s_lshl_b32 s61, s61, 6
    s_add_u32 s61, s61, 131072
    v_add_u32 v10, s61, v10
    v_xor_b32 v11, v3, v4
    v_lshlrev_b32 v11, 4, v11
    v_lshl_add_u32 v11, v3, 9, v11
    s_lshl_b32 s61, s60, 14
    v_add_u32 v11, s61, v11
    v_xor_b32 v12, 64, v11
    v_xor_b32 v13, 128, v11
    v_xor_b32 v14, 192, v11
    v_and_b32 v15, 7, v8
    v_lshlrev_b32 v15, 1, v15
    v_bfe_u32 v16, v0, 1, 1
    s_lshl_b32 s61, s60, 2
    v_add_u32 v16, s61, v16
    v_xor_b32 v15, v15, v16
    v_lshlrev_b32 v15, 4, v15
    v_lshl_add_u32 v15, v8, 9, v15
    v_and_b32 v16, 1, v0
    v_lshl_add_u32 v15, v16, 3, v15
    v_mul_u32_u24 v17, 528, v16
    v_lshl_add_u32 v17, v4, 4, v17
    v_add_u32 v17, v2, v17
    v_lshl_add_u32 v18, v16, 2, v2
    v_xor_b32 v16, 32, v15
    s_waitcnt lgkmcnt(0)
    s_mov_b32 s44, s38
    s_mov_b32 s45, s39
    s_mov_b32 s46, 2490368
    s_mov_b32 s47, 0x20000
    s_lshl_b32 s61, s60, 4
    s_add_u32 s61, s61, 16
    s_barrier
    s_setprio 1
L_sp17:
    ds_read_b32 v19, v2 offset:2576
    s_sub_u32 s43, s43, 1
    s_cbranch_scc1 L_end
    s_sleep 2
    s_waitcnt lgkmcnt(0)
    v_readfirstlane_b32 s42, v19
    s_cmp_ge_u32 s42, s61
    s_cbranch_scc0 L_sp17
    ds_read_b128 v[32:35], v11 offset:0
    ds_read_b128 v[36:39], v12 offset:0
    ds_read_b128 v[40:43], v13 offset:0
    ds_read_b128 v[44:47], v14 offset:0
    ds_read_b128 v[48:51], v11 offset:256
    ds_read_b128 v[52:55], v12 offset:256
    ds_read_b128 v[56:59], v13 offset:256
    ds_read_b128 v[60:63], v14 offset:256
    ds_read_b128 v[64:67], v11 offset:8192
    ds_read_b128 v[68:71], v12 offset:8192
    ds_read_b128 v[72:75], v13 offset:8192
    ds_read_b128 v[76:79], v14 offset:8192
    ds_read_b128 v[80:83], v11 offset:8448
    ds_read_b128 v[84:87], v12 offset:8448
    ds_read_b128 v[88:91], v13 offset:8448
    ds_read_b128 v[92:95], v14 offset:8448
    s_lshl_b32 s62, s60, 2
    v_add_u32 v19, s62, v2
    s_and_b32 s59, s60, 1
    v_and_b32 v5, 7, v0
    v_cmp_eq_u32 vcc, 0, v5
    v_lshlrev_b32 v5, 4, v4
    v_lshl_add_u32 v5, v3, 3, v5
    s_lshl_b32 s58, s59, 7
    v_add_u32 v5, s58, v5
    v_mov_b32 v21, 256
    v_cndmask_b32 v5, v21, v5, vcc
    v_add_u32 v5, v2, v5
    v_lshrrev_b32 v8, 1, v4
    v_lshl_add_u32 v8, v8, 2, v2
    s_lshl_b32 s58, s59, 3
    v_add_u32 v8, s58, v8
    s_waitcnt lgkmcnt(0)
    ds_write_b32 v19, v1 offset:2608
L_sp18:
    ds_read_b32 v19, v2 offset:2584
    s_sub_u32 s43, s43, 1
    s_cbranch_scc1 L_end
    s_sleep 1
    s_waitcnt lgkmcnt(0)
    v_readfirstlane_b32 s42, v19
    s_cmp_ge_u32 s42, 1
    s_cbranch_scc0 L_sp18
    ds_read_b64 v[6:7], v2 offset:2272
    ds_read_b128 v[128:131], v17 offset:0
    ds_read_b128 v[132:135], v17 offset:64
    ds_read_b128 v[136:139], v17 offset:128
    ds_read_b128 v[140:143], v17 offset:192
    ds_read_b128 v[144:147], v17 offset:256
    ds_read_b128 v[148:151], v17 offset:320
    ds_read_b128 v[152:155], v17 offset:384
    ds_read_b128 v[156:159], v17 offset:448
    s_waitcnt lgkmcnt(7)
    v_mfma_f32_16x16x32_bf16 v[20:23], v[128:131], v[32:35], 0
    v_mfma_f32_16x16x32_bf16 v[24:27], v[128:131], v[64:67], 0
    s_waitcnt lgkmcnt(6)
    v_mfma_f32_16x16x32_bf16 v[20:23], v[132:135], v[36:39], v[20:23]
    v_mfma_f32_16x16x32_bf16 v[24:27], v[132:135], v[68:71], v[24:27]
    s_waitcnt lgkmcnt(5)
    v_mfma_f32_16x16x32_bf16 v[20:23], v[136:139], v[40:43], v[20:23]
    v_mfma_f32_16x16x32_bf16 v[24:27], v[136:139], v[72:75], v[24:27]
    s_waitcnt lgkmcnt(4)
    v_mfma_f32_16x16x32_bf16 v[20:23], v[140:143], v[44:47], v[20:23]
    v_mfma_f32_16x16x32_bf16 v[24:27], v[140:143], v[76:79], v[24:27]
    s_waitcnt lgkmcnt(3)
    v_mfma_f32_16x16x32_bf16 v[20:23], v[144:147], v[48:51], v[20:23]
    v_mfma_f32_16x16x32_bf16 v[24:27], v[144:147], v[80:83], v[24:27]
    s_waitcnt lgkmcnt(2)
    v_mfma_f32_16x16x32_bf16 v[20:23], v[148:151], v[52:55], v[20:23]
    v_mfma_f32_16x16x32_bf16 v[24:27], v[148:151], v[84:87], v[24:27]
    s_waitcnt lgkmcnt(1)
    v_mfma_f32_16x16x32_bf16 v[20:23], v[152:155], v[56:59], v[20:23]
    v_mfma_f32_16x16x32_bf16 v[24:27], v[152:155], v[88:91], v[24:27]
    s_waitcnt lgkmcnt(0)
    v_mfma_f32_16x16x32_bf16 v[20:23], v[156:159], v[60:63], v[20:23]
    v_mfma_f32_16x16x32_bf16 v[24:27], v[156:159], v[92:95], v[24:27]
    v_readfirstlane_b32 s40, v6
    v_readfirstlane_b32 s41, v7
    s_lshl_b32 s62, s60, 3
    v_add_u32 v19, s62, v2
    v_and_b32 v32, 7, v0
    v_lshl_add_u32 v32, v32, 3, v2
    s_mov_b32 s63, 0x3db8aa3b
    s_nop 3
    v_cvt_pk_bf16_f32 v20, v20, v21
    v_cvt_pk_bf16_f32 v24, v24, v25
    v_and_b32 v21, 0xffff0000, v20
    v_lshlrev_b32 v20, 16, v20
    v_and_b32 v25, 0xffff0000, v24
    v_lshlrev_b32 v24, 16, v24
    v_max_f32 v22, v20, v24
    v_max_f32 v23, v21, v25
    s_nop 0
    v_max_f32_dpp v22, v22, v22 row_ror:8 row_mask:0xf bank_mask:0xf
    v_max_f32_dpp v23, v23, v23 row_ror:8 row_mask:0xf bank_mask:0xf
    s_nop 0
    v_max_f32_dpp v22, v22, v22 row_ror:4 row_mask:0xf bank_mask:0xf
    v_max_f32_dpp v23, v23, v23 row_ror:4 row_mask:0xf bank_mask:0xf
    s_nop 0
    v_max_f32_dpp v22, v22, v22 row_ror:2 row_mask:0xf bank_mask:0xf
    v_max_f32_dpp v23, v23, v23 row_ror:2 row_mask:0xf bank_mask:0xf
    s_nop 0
    v_max_f32_dpp v22, v22, v22 row_ror:1 row_mask:0xf bank_mask:0xf
    v_max_f32_dpp v23, v23, v23 row_ror:1 row_mask:0xf bank_mask:0xf
    ds_write_b64 v19, v[22:23] offset:2112
    s_waitcnt lgkmcnt(0)
    s_mov_b64 exec, 1
    ds_add_u32 v2, v1 offset:2588
    s_mov_b64 exec, -1
L_sp19:
    ds_read_b32 v33, v2 offset:2588
    s_sub_u32 s43, s43, 1
    s_cbranch_scc1 L_end
    s_waitcnt lgkmcnt(0)
    v_readfirstlane_b32 s42, v33
    s_cmp_ge_u32 s42, 8
    s_cbranch_scc0 L_sp19
    ds_read_b64 v[22:23], v32 offset:2112
    s_waitcnt lgkmcnt(0)
    s_nop 0
    v_max_f32_dpp v22, v22, v22 row_ror:4 row_mask:0xf bank_mask:0xf
    v_max_f32_dpp v23, v23, v23 row_ror:4 row_mask:0xf bank_mask:0xf
    s_nop 0
    v_max_f32_dpp v22, v22, v22 row_ror:2 row_mask:0xf bank_mask:0xf
    v_max_f32_dpp v23, v23, v23 row_ror:2 row_mask:0xf bank_mask:0xf
    s_nop 0
    v_max_f32_dpp v22, v22, v22 row_ror:1 row_mask:0xf bank_mask:0xf
    v_max_f32_dpp v23, v23, v23 row_ror:1 row_mask:0xf bank_mask:0xf
    v_lshrrev_b32 v34, 2, v3
    v_lshlrev_b32 v34, 4, v34
    v_lshl_add_u32 v34, v9, 1, v34
    s_lshl_b32 s62, s60, 6
    v_add3_u32 v34, v34, s62, v2
    ds_write_b64 v2, v[22:23] offset:2240
    v_sub_f32 v20, v20, v22
    v_sub_f32 v21, v21, v23
    v_sub_f32 v24, v24, v22
    v_sub_f32 v25, v25, v23
    v_mul_f32 v20, s63, v20
    v_mul_f32 v21, s63, v21
    v_mul_f32 v24, s63, v24
    v_mul_f32 v25, s63, v25
    v_exp_f32 v20, v20
    v_exp_f32 v21, v21
    v_exp_f32 v24, v24
    v_exp_f32 v25, v25
    s_nop 0
    v_add_f32 v22, v20, v24
    v_add_f32 v23, v21, v25
    v_cvt_pk_bf16_f32 v20, v20, v21
    v_cvt_pk_bf16_f32 v24, v24, v25
    s_mov_b64 exec, 0xffff
    ds_write_b16 v34, v20 offset:1056
    ds_write_b16_d16_hi v34, v20 offset:1584
    ds_write_b16 v34, v24 offset:1064
    ds_write_b16_d16_hi v34, v24 offset:1592
    s_mov_b64 exec, -1
    s_nop 0
    v_add_f32_dpp v22, v22, v22 row_ror:8 row_mask:0xf bank_mask:0xf
    v_add_f32_dpp v23, v23, v23 row_ror:8 row_mask:0xf bank_mask:0xf
    s_nop 0
    v_add_f32_dpp v22, v22, v22 row_ror:4 row_mask:0xf bank_mask:0xf
    v_add_f32_dpp v23, v23, v23 row_ror:4 row_mask:0xf bank_mask:0xf
    s_nop 0
    v_add_f32_dpp v22, v22, v22 row_ror:2 row_mask:0xf bank_mask:0xf
    v_add_f32_dpp v23, v23, v23 row_ror:2 row_mask:0xf bank_mask:0xf
    s_nop 0
    v_add_f32_dpp v22, v22, v22 row_ror:1 row_mask:0xf bank_mask:0xf
    v_add_f32_dpp v23, v23, v23 row_ror:1 row_mask:0xf bank_mask:0xf
    ds_write_b64 v19, v[22:23] offset:2176
    s_waitcnt lgkmcnt(0)
    s_mov_b64 exec, 1
    ds_add_u32 v2, v1 offset:2592
    s_mov_b64 exec, -1
L_sp20:
    ds_read_b32 v33, v2 offset:2592
    s_sub_u32 s43, s43, 1
    s_cbranch_scc1 L_end
    s_waitcnt lgkmcnt(0)
    v_readfirstlane_b32 s42, v33
    s_cmp_ge_u32 s42, 8
    s_cbranch_scc0 L_sp20
    ds_read_b128 v[128:131], v17 offset:1056
    ds_read_b128 v[132:135], v17 offset:1120
    ds_read_b128 v[136:139], v17 offset:1184
    ds_read_b128 v[140:143], v17 offset:1248
    ds_read_b128 v[144:147], v17 offset:1312
    ds_read_b128 v[148:151], v17 offset:1376
    ds_read_b128 v[152:155], v17 offset:1440
    ds_read_b128 v[156:159], v17 offset:1504
    v_add_u32 v32, 0x10000, v15
    v_add_u32 v33, 0x10000, v16
    v_and_b32 v34, 1, v0
    v_lshlrev_b32 v34, 1, v34
    v_bfe_u32 v35, v0, 1, 1
    v_add_u32 v34, v34, v35
    v_lshl_add_u32 v34, v34, 2, v4
    v_lshlrev_b32 v34, 4, v34
    v_and_b32 v35, 7, v3
    v_xor_b32 v35, v35, v4
    v_lshlrev_b32 v35, 4, v35
    v_lshl_add_u32 v35, v3, 7, v35
    s_lshl_b32 s62, s59, 11
    s_add_u32 s62, s62, 155648
    v_add_u32 v35, s62, v35
    v_xor_b32 v38, 64, v35
    s_lshl_b32 s62, s60, 2
    v_add_u32 v39, s62, v4
    v_and_b32 v30, 7, v39
    v_lshrrev_b32 v31, 1, v3
    v_xor_b32 v30, v30, v31
    v_lshlrev_b32 v30, 4, v30
    v_lshl_add_u32 v39, v39, 7, v30
    v_and_b32 v30, 1, v0
    v_lshl_add_u32 v39, v30, 3, v39
    v_add_u32 v39, 155648, v39
    s_lshl_b32 s62, s4, 16
    s_add_u32 s62, s62, 196608
    s_lshl_b32 s63, s60, 13
    s_lshl_b32 s64, s5, 11
    s_and_b32 s64, s64, 0x1800
    s_add_u32 s63, s63, s64
    s_lshl_b32 s64, s7, 8
    s_add_u32 s63, s63, s64
    s_add_u32 s63, s63, s62
    s_lshl_b32 s64, s7, 13
    s_add_u32 s62, s62, s64
    s_lshl_b32 s64, s60, 10
    s_add_u32 s62, s62, s64
    s_lshl_b32 s64, s6, 1
    s_add_u32 s64, s64, s59
    s_lshl_b32 s64, s64, 6
    s_lshl_b32 s65, s4, 3
    s_add_u32 s64, s64, s65
    s_add_u32 s64, s64, s7
    s_lshl_b32 s64, s64, 11
    s_lshr_b32 s65, s60, 1
    s_lshl_b32 s65, s65, 9
    s_add_u32 s64, s64, s65
    s_add_u32 s64, s64, 1048576
    v_lshlrev_b32 v36, 4, v0
    v_and_b32 v37, 2, v0
    v_cmp_ne_u32 s[66:67], 0, v37
    v_mov_b32 v58, s40
    v_mov_b32 v59, s41
L_sp21:
    ds_read_b32 v19, v2 offset:2576
    s_sub_u32 s43, s43, 1
    s_cbranch_scc1 L_end
    s_sleep 1
    s_waitcnt lgkmcnt(0)
    v_readfirstlane_b32 s42, v19
    s_cmp_ge_u32 s42, 144
    s_cbranch_scc0 L_sp21
    ds_read_b64_tr_b16 v[40:41], v15 offset:0
    ds_read_b64_tr_b16 v[42:43], v15 offset:8192
    ds_read_b64_tr_b16 v[44:45], v16 offset:0
    ds_read_b64_tr_b16 v[46:47], v16 offset:8192
    s_waitcnt lgkmcnt(2)
    v_mfma_f32_16x16x32_bf16 v[48:51], v[40:43], v[128:131], 0
    s_waitcnt lgkmcnt(0)
    v_mfma_f32_16x16x32_bf16 v[52:55], v[44:47], v[128:131], 0
L_sp22:
    ds_read_b32 v19, v2 offset:2576
    s_sub_u32 s43, s43, 1
    s_cbranch_scc1 L_end
    s_sleep 1
    s_waitcnt lgkmcnt(0)
    v_readfirstlane_b32 s42, v19
    s_cmp_ge_u32 s42, 160
    s_cbranch_scc0 L_sp22
    ds_read_b64_tr_b16 v[40:41], v15 offset:16384
    ds_read_b64_tr_b16 v[42:43], v15 offset:24576
    ds_read_b64_tr_b16 v[44:45], v16 offset:16384
    ds_read_b64_tr_b16 v[46:47], v16 offset:24576
    s_waitcnt lgkmcnt(2)
    v_mfma_f32_16x16x32_bf16 v[48:51], v[40:43], v[132:135], v[48:51]
    s_waitcnt lgkmcnt(0)
    v_mfma_f32_16x16x32_bf16 v[52:55], v[44:47], v[132:135], v[52:55]
L_sp23:
    ds_read_b32 v19, v2 offset:2576
    s_sub_u32 s43, s43, 1
    s_cbranch_scc1 L_end
    s_sleep 1
    s_waitcnt lgkmcnt(0)
    v_readfirstlane_b32 s42, v19
    s_cmp_ge_u32 s42, 176
    s_cbranch_scc0 L_sp23
    ds_read_b64_tr_b16 v[40:41], v15 offset:32768
    ds_read_b64_tr_b16 v[42:43], v15 offset:40960
    ds_read_b64_tr_b16 v[44:45], v16 offset:32768
    ds_read_b64_tr_b16 v[46:47], v16 offset:40960
    s_waitcnt lgkmcnt(2)
    v_mfma_f32_16x16x32_bf16 v[48:51], v[40:43], v[136:139], v[48:51]
    s_waitcnt lgkmcnt(0)
    v_mfma_f32_16x16x32_bf16 v[52:55], v[44:47], v[136:139], v[52:55]
L_sp24:
    ds_read_b32 v19, v2 offset:2576
    s_sub_u32 s43, s43, 1
    s_cbranch_scc1 L_end
    s_sleep 1
    s_waitcnt lgkmcnt(0)
    v_readfirstlane_b32 s42, v19
    s_cmp_ge_u32 s42, 192
    s_cbranch_scc0 L_sp24
    ds_read_b64_tr_b16 v[40:41], v15 offset:49152
    ds_read_b64_tr_b16 v[42:43], v15 offset:57344
    ds_read_b64_tr_b16 v[44:45], v16 offset:49152
    ds_read_b64_tr_b16 v[46:47], v16 offset:57344
    s_waitcnt lgkmcnt(2)
    v_mfma_f32_16x16x32_bf16 v[48:51], v[40:43], v[140:143], v[48:51]
    s_waitcnt lgkmcnt(0)
    v_mfma_f32_16x16x32_bf16 v[52:55], v[44:47], v[140:143], v[52:55]
L_sp25:
    ds_read_b32 v19, v2 offset:2576
    s_sub_u32 s43, s43, 1
    s_cbranch_scc1 L_end
    s_sleep 1
    s_waitcnt lgkmcnt(0)
    v_readfirstlane_b32 s42, v19
    s_cmp_ge_u32 s42, 208
    s_cbranch_scc0 L_sp25
    ds_read_b64_tr_b16 v[40:41], v32 offset:0
    ds_read_b64_tr_b16 v[42:43], v32 offset:8192
    ds_read_b64_tr_b16 v[44:45], v33 offset:0
    ds_read_b64_tr_b16 v[46:47], v33 offset:8192
    s_waitcnt lgkmcnt(2)
    v_mfma_f32_16x16x32_bf16 v[48:51], v[40:43], v[144:147], v[48:51]
    s_waitcnt lgkmcnt(0)
    v_mfma_f32_16x16x32_bf16 v[52:55], v[44:47], v[144:147], v[52:55]
L_sp26:
    ds_read_b32 v19, v2 offset:2576
    s_sub_u32 s43, s43, 1
    s_cbranch_scc1 L_end
    s_sleep 1
    s_waitcnt lgkmcnt(0)
    v_readfirstlane_b32 s42, v19
    s_cmp_ge_u32 s42, 224
    s_cbranch_scc0 L_sp26
    ds_read_b64_tr_b16 v[40:41], v32 offset:16384
    ds_read_b64_tr_b16 v[42:43], v32 offset:24576
    ds_read_b64_tr_b16 v[44:45], v33 offset:16384
    ds_read_b64_tr_b16 v[46:47], v33 offset:24576
    s_waitcnt lgkmcnt(2)
    v_mfma_f32_16x16x32_bf16 v[48:51], v[40:43], v[148:151], v[48:51]
    s_waitcnt lgkmcnt(0)
    v_mfma_f32_16x16x32_bf16 v[52:55], v[44:47], v[148:151], v[52:55]
L_sp27:
    ds_read_b32 v19, v2 offset:2576
    s_sub_u32 s43, s43, 1
    s_cbranch_scc1 L_end
    s_waitcnt lgkmcnt(0)
    v_readfirstlane_b32 s42, v19
    s_cmp_ge_u32 s42, 240
    s_cbranch_scc0 L_sp27
    ds_read_b64_tr_b16 v[40:41], v32 offset:32768
    ds_read_b64_tr_b16 v[42:43], v32 offset:40960
    ds_read_b64_tr_b16 v[44:45], v33 offset:32768
    ds_read_b64_tr_b16 v[46:47], v33 offset:40960
    s_waitcnt lgkmcnt(2)
    v_mfma_f32_16x16x32_bf16 v[48:51], v[40:43], v[152:155], v[48:51]
    s_waitcnt lgkmcnt(0)
    v_mfma_f32_16x16x32_bf16 v[52:55], v[44:47], v[152:155], v[52:55]
L_sp28:
    ds_read_b32 v19, v2 offset:2576
    s_sub_u32 s43, s43, 1
    s_cbranch_scc1 L_end
    s_waitcnt lgkmcnt(0)
    v_readfirstlane_b32 s42, v19
    s_cmp_ge_u32 s42, 256
    s_cbranch_scc0 L_sp28
    s_setprio 3
    ds_read_b64_tr_b16 v[40:41], v32 offset:49152
    ds_read_b64_tr_b16 v[42:43], v32 offset:57344
    ds_read_b64_tr_b16 v[44:45], v33 offset:49152
    ds_read_b64_tr_b16 v[46:47], v33 offset:57344
    s_waitcnt lgkmcnt(2)
    v_mfma_f32_16x16x32_bf16 v[48:51], v[40:43], v[156:159], v[48:51]
    s_waitcnt lgkmcnt(0)
    v_mfma_f32_16x16x32_bf16 v[52:55], v[44:47], v[156:159], v[52:55]
    s_nop 7
    v_cndmask_b32 v48, v48, v52, s[66:67]
    v_cndmask_b32 v49, v49, v53, s[66:67]
    v_cndmask_b32 v50, v50, v54, s[66:67]
    v_cndmask_b32 v51, v51, v55, s[66:67]
    v_cvt_pk_bf16_f32 v56, v48, v49
    v_cvt_pk_bf16_f32 v57, v50, v51
    s_mov_b32 exec_lo, 0x000f000f
    s_mov_b32 exec_hi, 0x000f000f
    buffer_store_dwordx4 v[56:59], v34, s[44:47], s63 offen sc1
    s_mov_b64 exec, -1
    buffer_load_dwordx4 v[60:63], v36, s[44:47], s62 offen sc1
    s_lshl_b32 s65, s59, 6
    v_lshl_add_u32 v37, v4, 4, v2
    v_add_u32 v37, s65, v37
    s_setprio 0
L_sp29:
    ds_read_b32 v19, v2 offset:2576
    s_sub_u32 s43, s43, 1
    s_cbranch_scc1 L_end
    s_waitcnt lgkmcnt(0)
    v_readfirstlane_b32 s42, v19
    s_cmp_ge_u32 s42, 280
    s_cbranch_scc0 L_sp29
    s_setprio 1
    ds_read_b64_tr_b16 v[96:97], v10 offset:0
    ds_read_b64_tr_b16 v[98:99], v10 offset:1024
    ds_read_b64_tr_b16 v[100:101], v10 offset:32
    ds_read_b64_tr_b16 v[102:103], v10 offset:1056
    ds_read_b64_tr_b16 v[104:105], v10 offset:8192
    ds_read_b64_tr_b16 v[106:107], v10 offset:9216
    ds_read_b64_tr_b16 v[108:109], v10 offset:8224
    ds_read_b64_tr_b16 v[110:111], v10 offset:9248
    ds_read_b64_tr_b16 v[112:113], v10 offset:16384
    ds_read_b64_tr_b16 v[114:115], v10 offset:17408
    ds_read_b64_tr_b16 v[116:117], v10 offset:16416
    ds_read_b64_tr_b16 v[118:119], v10 offset:17440
L_sp30:
    ds_read_b32 v19, v2 offset:2596
    s_sub_u32 s43, s43, 1
    s_cbranch_scc1 L_end
    s_sleep 1
    s_waitcnt lgkmcnt(0)
    v_readfirstlane_b32 s42, v19
    s_cmp_ge_u32 s42, 1
    s_cbranch_scc0 L_sp30
    ds_read_b128 v[24:27], v5 offset:2304
    ds_read_b32 v23, v8 offset:2256
    ds_read_b128 v[84:87], v37 offset:3840
    ds_read_b128 v[88:91], v37 offset:3968
    s_waitcnt lgkmcnt(2)
    v_mfma_f32_16x16x32_bf16 v[40:43], v[24:27], v[112:115], 0
    v_mfma_f32_16x16x32_bf16 v[44:47], v[24:27], v[116:119], 0
    s_nop 7
    v_mul_f32 v28, v23, v40
    v_mul_f32 v29, v23, v44
    s_branch L_pc
L_po:
    s_mov_b64 exec, vcc
    buffer_load_dwordx4 v[60:63], v36, s[44:47], s62 offen sc1
    s_mov_b64 exec, -1
    s_sub_u32 s43, s43, 16
    s_cbranch_scc1 L_end
    L_pc:
    s_waitcnt vmcnt(0)
    v_cmp_ne_u64 vcc, s[40:41], v[62:63]
    s_cbranch_vccnz L_po
    s_setprio 3
    ds_write_b64 v39, v[60:61]
    s_waitcnt lgkmcnt(0)
    s_mov_b64 exec, 1
    ds_add_u32 v2, v1 offset:2604
    s_mov_b64 exec, -1
    s_setprio 0
L_sp31:
    ds_read_b32 v19, v2 offset:2604
    s_sub_u32 s43, s43, 1
    s_cbranch_scc1 L_end
    s_waitcnt lgkmcnt(0)
    v_readfirstlane_b32 s42, v19
    s_cmp_ge_u32 s42, 8
    s_cbranch_scc0 L_sp31
    s_setprio 3
    ds_read_b128 v[48:51], v35
    ds_read_b128 v[68:71], v38
    s_waitcnt lgkmcnt(0)
    v_mfma_f32_16x16x32_bf16 v[76:79], v[48:51], v[96:99], 0
    v_mfma_f32_16x16x32_bf16 v[80:83], v[48:51], v[100:103], 0
    v_mfma_f32_16x16x32_bf16 v[112:115], v[68:71], v[104:107], 0
    v_mfma_f32_16x16x32_bf16 v[116:119], v[68:71], v[108:111], 0
    s_nop 4
    v_fmac_f32 v28, v84, v76
    v_fmac_f32 v29, v84, v80
    v_fmac_f32 v28, v85, v77
    v_fmac_f32 v29, v85, v81
    v_fmac_f32 v28, v86, v78
    v_fmac_f32 v29, v86, v82
    v_fmac_f32 v28, v87, v79
    v_fmac_f32 v29, v87, v83
    v_mul_f32 v76, v88, v112
    v_mul_f32 v80, v88, v116
    v_fmac_f32 v76, v89, v113
    v_fmac_f32 v80, v89, v117
    v_fmac_f32 v76, v90, v114
    v_fmac_f32 v80, v90, v118
    v_fmac_f32 v76, v91, v115
    v_fmac_f32 v80, v91, v119
    v_add_f32 v76, v76, v28
    v_add_f32 v80, v80, v29
    s_nop 1
    v_permlane16_swap_b32 v76, v80
    v_add_f32 v56, v76, v80
    v_add_f32 v57, v76, v80
    s_nop 1
    v_permlane32_swap_b32 v56, v57
    s_mov_b32 exec_hi, 0
    buffer_store_dwordx4 v[56:59], v36, s[44:47], s64 offen sc1
    s_mov_b64 exec, 1
    ds_add_u32 v2, v1 offset:2640
L_end:
L_exit:
    s_endpgm
.section .rodata,"a"
.p2align 6
.amdhsa_kernel gated_mix__sliding_block_cached__dense_activation_relu__decode_kernel
  .amdhsa_next_free_vgpr 160
  .amdhsa_next_free_sgpr 102
  .amdhsa_accum_offset 160
  .amdhsa_group_segment_fixed_size 0
  .amdhsa_kernarg_size 96
  .amdhsa_user_sgpr_count 2
  .amdhsa_user_sgpr_kernarg_segment_ptr 1
  .amdhsa_system_sgpr_workgroup_id_x 1
.end_amdhsa_kernel
```
